```python
import torch

def _softmax(x, axis=-1):
    return torch.softmax(x, dim=axis)
def _gelu(x):
    return torch.nn.functional.gelu(x, approximate="tanh")
def _silu(x):
    return torch.nn.functional.silu(x)
def _sigmoid(x):
    return torch.sigmoid(x)
def _layernorm(x, axis=-1, eps=1e-5):
    m = x.mean(dim=axis, keepdim=True)
    v = x.var(dim=axis, keepdim=True, unbiased=False)
    return (x - m) / torch.sqrt(v + eps)
def _scatter_add(tgt, idx, src, axis=0):
    return tgt.clone().index_add_(axis, idx, src)
def _segment_sum(src, seg, n):
    out = torch.zeros((n,) + src.shape[1:], dtype=src.dtype)
    return out.index_add_(0, seg, src)
def _pad(x, pw):
    flat = tuple(v for pair in reversed(pw) for v in pair)
    return torch.nn.functional.pad(x, flat)

kernel_name = 'gated_mix__sliding_block_cached__swiglu_ffn__decode'

def setup_inputs():

    _w = (lambda a: (lambda t: t.to(torch.bfloat16) if t.is_floating_point() else t)(torch.as_tensor(a)))
    def _A_setup():
        B, Sq, D = 1, 1, 448
        Hq, Hkv, Sk, Dh = 16, 8, 65536, 256
        assert Hq % Hkv == 0, (Hq, Hkv)
        return {
            "x": _w((lambda *s: torch.randn(*s, dtype=torch.bfloat16) * 0.05)(B, Sq, D)),
            "k_cache": _w((lambda *s: torch.randn(*s, dtype=torch.bfloat16) * 3.2)(B, Hkv, Sk, Dh)),
            "v_cache": _w((lambda *s: torch.randn(*s, dtype=torch.bfloat16) * 0.4)(B, Hkv, Sk, Dh)),
            "wq": _w((lambda *s: torch.randn(*s, dtype=torch.bfloat16) * 3.2)(D, Hq * Dh) * (D ** -0.5)),
            "wo": _w((lambda *s: torch.randn(*s, dtype=torch.bfloat16) * 0.4)(Hq * Dh, D) * ((Hq * Dh) ** -0.5)),
        }
    _A_in = _A_setup()

    def _B_setup():
        B, S, D, F = 1, 1, 448, 1792
        return {
            "x": _w((lambda *s: torch.randn(*s, dtype=torch.bfloat16) * 0.05)(B, S, D)),
            "w_gate": _w((lambda *s: torch.randn(*s, dtype=torch.bfloat16) * 0.05)(D, F)),
            "w_up": _w((lambda *s: torch.randn(*s, dtype=torch.bfloat16) * 0.05)(D, F)),
            "w_down": _w((lambda *s: torch.randn(*s, dtype=torch.bfloat16) * 0.05)(F, D)),
        }
    _B_in = _B_setup()

    return {
        "A_x": _A_in["x"],
        "A_k_cache": _A_in["k_cache"],
        "A_v_cache": _A_in["v_cache"],
        "A_wq": _A_in["wq"],
        "A_wo": _A_in["wo"],
        "B_x": _B_in["x"],
        "B_w_gate": _B_in["w_gate"],
        "B_w_up": _B_in["w_up"],
        "B_w_down": _B_in["w_down"],
        "gate_w": _w((lambda *s: torch.randn(*s, dtype=torch.bfloat16) * 0.05)(448) * 16.0),
    }

def reference(A_x, A_k_cache, A_v_cache, A_wq, A_wo, B_x, B_w_gate, B_w_up, B_w_down, gate_w):
    def _A_ref(x, k_cache, v_cache, wq, wo):
        B, Sq, D = x.shape
        Hq, Dh = 16, 256
        Hkv, Sk = k_cache.shape[1], k_cache.shape[2]
        W = min(4096, max(256, Sk // 4))
        rep = Hq // Hkv
        q = (lambda x, *d: x.permute(*d))((x @ wq).reshape(B, Sq, Hq, Dh), 0, 2, 1, 3)
        k = (lambda x, n, axis: torch.repeat_interleave(x, n, dim=axis))(k_cache[:, :, Sk - W:, :], rep, axis=1)
        v = (lambda x, n, axis: torch.repeat_interleave(x, n, dim=axis))(v_cache[:, :, Sk - W:, :], rep, axis=1)
        scores = torch.einsum("bhqd,bhkd->bhqk", q, k) * (Dh ** -0.5)
        p = _softmax(scores, axis=-1)
        o = torch.einsum("bhqk,bhkd->bhqd", p, v)
        return (lambda x, *d: x.permute(*d))(o, 0, 2, 1, 3).reshape(B, Sq, Hq * Dh) @ wo

    def _B_ref(x, w_gate, w_up, w_down):
        g = _silu(x @ w_gate)
        u = x @ w_up
        return (g * u) @ w_down

    x = A_x
    g = _sigmoid((x * gate_w).sum(-1, keepdims=True))
    a = _A_ref(x, A_k_cache, A_v_cache, A_wq, A_wo)
    b = _B_ref(x, B_w_gate, B_w_up, B_w_down)
    return g * a + (1 - g) * b
```

```asm
; @launch grid=(256,1,1) block=(640,1,1) lds=17408
.amdgcn_target "amdgcn-amd-amdhsa--gfx950"
.text
.globl gated_mix__sliding_block_cached__swiglu_ffn__decode_kernel
.p2align 8
.type gated_mix__sliding_block_cached__swiglu_ffn__decode_kernel,@function
gated_mix__sliding_block_cached__swiglu_ffn__decode_kernel:
    s_cmp_ge_u32 s2, 256
    s_cbranch_scc1 L_end
    s_load_dwordx16 s[8:23], s[0:1], 0
    s_load_dwordx8 s[24:31], s[0:1], 64
    s_load_dwordx2 s[32:33], s[0:1], 96
    v_lshrrev_b32 v1, 6, v0
    v_and_b32 v0, 63, v0
    s_and_b32 s4, s2, 7
    v_readfirstlane_b32 s3, v1
    s_lshr_b32 s5, s2, 3
    s_lshr_b32 s60, s5, 3
    s_and_b32 s7, s5, 7
    s_mov_b32 s58, 0x6c888480
    s_mov_b32 s59, 0x7976926f
    s_lshl_b32 s61, s4, 3
    s_lshr_b64 s[58:59], s[58:59], s61
    s_bfe_u32 s61, s58, 0x30005
    s_and_b32 s58, s58, 31
    s_add_u32 s58, s58, s60
    s_min_u32 s58, s58, 27
    s_cmp_lt_u32 s60, s61
    s_cselect_b32 s59, 1, 0
    s_cmp_ge_u32 s3, 2
    s_cbranch_scc1 L_stream
    s_mul_i32 s35, s60, 917504
    s_lshl_b32 s36, s4, 10
    s_lshl_b32 s37, s7, 7
    s_add_u32 s35, s35, s36
    s_add_u32 s35, s35, s37
    s_mul_i32 s36, s7, 200704
    s_lshl_b32 s37, s58, 7
    s_add_u32 s36, s36, s37
    s_mul_i32 s38, s60, 224
    s_mul_i32 s39, s7, 112
    s_movk_i32 s37, 3584
    s_cmp_eq_u32 s3, 0
    s_cselect_b32 s35, s35, s36
    s_cselect_b32 s38, s38, s39
    s_cselect_b32 s36, 8192, s37
    s_mov_b32 s37, 0
    s_add_u32 s39, s3, 3
    s_mul_i32 s41, s36, 14
    v_lshrrev_b32 v5, s39, v0
    v_and_b32 v6, 7, v0
    v_and_b32 v7, 8, v0
    v_mul_u32_u24 v2, s41, v5
    v_mul_u32_u24 v4, 28, v5
    v_lshl_add_u32 v2, v6, 4, v2
    v_add_u32 v4, s38, v4
    v_add_u32 v2, s35, v2
    v_cmp_ne_u32 vcc, 0, v7
    v_mov_b32 v3, 0
    ds_write_b32 v3, v3 offset:1220
    s_andn2_b32 s38, s3, s59
    s_cmp_eq_u32 s3, 0
    s_waitcnt lgkmcnt(0)
    s_cselect_b64 s[20:21], s[14:15], s[20:21]
    s_cselect_b64 s[22:23], s[14:15], s[22:23]
    s_load_dword s34, s[32:33], 12
    v_mov_b32 v16, s20
    v_mov_b32 v17, s21
    v_mov_b32 v18, s22
    v_mov_b32 v19, s23
    v_cndmask_b32 v16, v16, v18, vcc
    v_cndmask_b32 v17, v17, v19, vcc
    s_cmp_lg_u32 s38, 0
    v_lshl_add_u64 v[2:3], v[2:3], 0, v[16:17]
    s_cbranch_scc1 L_h1_nogemv
    global_load_dwordx4 v[16:19], v4, s[8:9]
    global_load_dwordx3 v[20:22], v4, s[8:9] offset:16
    global_load_dwordx4 v[24:27], v[2:3], off nt
    v_lshl_add_u64 v[2:3], v[2:3], 0, s[36:37]
    global_load_dwordx4 v[28:31], v[2:3], off nt
    v_lshl_add_u64 v[2:3], v[2:3], 0, s[36:37]
    global_load_dwordx4 v[32:35], v[2:3], off nt
    v_lshl_add_u64 v[2:3], v[2:3], 0, s[36:37]
    global_load_dwordx4 v[36:39], v[2:3], off nt
    v_lshl_add_u64 v[2:3], v[2:3], 0, s[36:37]
    global_load_dwordx4 v[40:43], v[2:3], off nt
    v_lshl_add_u64 v[2:3], v[2:3], 0, s[36:37]
    global_load_dwordx4 v[44:47], v[2:3], off nt
    v_lshl_add_u64 v[2:3], v[2:3], 0, s[36:37]
    global_load_dwordx4 v[48:51], v[2:3], off nt
    v_lshl_add_u64 v[2:3], v[2:3], 0, s[36:37]
    global_load_dwordx4 v[52:55], v[2:3], off nt
    v_lshl_add_u64 v[2:3], v[2:3], 0, s[36:37]
    global_load_dwordx4 v[56:59], v[2:3], off nt
    v_lshl_add_u64 v[2:3], v[2:3], 0, s[36:37]
    global_load_dwordx4 v[60:63], v[2:3], off nt
    v_lshl_add_u64 v[2:3], v[2:3], 0, s[36:37]
    global_load_dwordx4 v[64:67], v[2:3], off nt
    v_lshl_add_u64 v[2:3], v[2:3], 0, s[36:37]
    global_load_dwordx4 v[68:71], v[2:3], off nt
    v_lshl_add_u64 v[2:3], v[2:3], 0, s[36:37]
    global_load_dwordx4 v[72:75], v[2:3], off nt
    v_lshl_add_u64 v[2:3], v[2:3], 0, s[36:37]
    global_load_dwordx4 v[76:79], v[2:3], off nt
    s_barrier
    v_and_b32 v1, 1, v0
    v_bfe_u32 v15, v0, 1, 2
    v_mov_b32 v8, 0x0c0c0100
    v_mov_b32 v9, 0x01000c0c
    v_cmp_eq_u32 vcc, 1, v1
    v_mov_b32 v10, 0x0c0c0302
    v_mov_b32 v11, 0x03020c0c
    v_cndmask_b32 v1, v8, v9, vcc
    v_cndmask_b32 v14, v10, v11, vcc
    v_cmp_eq_u32 s[50:51], 0, v15
    v_cmp_eq_u32 s[52:53], 1, v15
    v_cmp_eq_u32 s[54:55], 2, v15
    v_cmp_eq_u32 vcc, 3, v15
    v_mov_b32 v15, 0x0c0c0c0c
    v_cndmask_b32 v8, v15, v1, s[50:51]
    v_cndmask_b32 v9, v15, v1, s[52:53]
    v_cndmask_b32 v10, v15, v1, s[54:55]
    v_cndmask_b32 v11, v15, v1, vcc
    v_cndmask_b32 v12, v15, v14, s[50:51]
    v_cndmask_b32 v13, v15, v14, s[52:53]
    v_cndmask_b32 v1, v15, v14, s[54:55]
    v_cndmask_b32 v15, v15, v14, vcc
    v_mov_b32 v14, v1
    s_mov_b32 s42, 0x07060502
    s_mov_b32 s43, 0x07060503
    s_movk_i32 s44, 0xf00
    s_mov_b32 s45, 0x04000c0c
    s_waitcnt lgkmcnt(0)
    s_and_b32 s34, s34, -16
    s_add_u32 s34, s34, 16
    s_max_u32 s34, s34, 16
    s_waitcnt vmcnt(14)
    v_perm_b32 v80, v16, v16, v8
    v_perm_b32 v81, v16, v16, v9
    v_perm_b32 v82, v16, v16, v10
    v_perm_b32 v83, v16, v16, v11
    v_perm_b32 v84, v16, v16, v12
    v_perm_b32 v85, v16, v16, v13
    v_perm_b32 v86, v16, v16, v14
    v_perm_b32 v87, v16, v16, v15
    v_perm_b32 v88, v17, v17, v8
    v_perm_b32 v89, v17, v17, v9
    v_perm_b32 v90, v17, v17, v10
    v_perm_b32 v91, v17, v17, v11
    v_perm_b32 v92, v17, v17, v12
    v_perm_b32 v93, v17, v17, v13
    v_perm_b32 v94, v17, v17, v14
    v_perm_b32 v95, v17, v17, v15
    v_perm_b32 v96, v18, v18, v8
    v_perm_b32 v97, v18, v18, v9
    v_perm_b32 v98, v18, v18, v10
    v_perm_b32 v99, v18, v18, v11
    v_perm_b32 v100, v18, v18, v12
    v_perm_b32 v101, v18, v18, v13
    v_perm_b32 v102, v18, v18, v14
    v_perm_b32 v103, v18, v18, v15
    v_perm_b32 v104, v19, v19, v8
    v_perm_b32 v105, v19, v19, v9
    v_perm_b32 v106, v19, v19, v10
    v_perm_b32 v107, v19, v19, v11
    v_perm_b32 v108, v19, v19, v12
    v_perm_b32 v109, v19, v19, v13
    v_perm_b32 v110, v19, v19, v14
    v_perm_b32 v111, v19, v19, v15
    v_perm_b32 v112, v20, v20, v8
    v_perm_b32 v113, v20, v20, v9
    v_perm_b32 v114, v20, v20, v10
    v_perm_b32 v115, v20, v20, v11
    v_perm_b32 v116, v20, v20, v12
    v_perm_b32 v117, v20, v20, v13
    v_perm_b32 v118, v20, v20, v14
    v_perm_b32 v119, v20, v20, v15
    v_perm_b32 v120, v21, v21, v8
    v_perm_b32 v121, v21, v21, v9
    v_perm_b32 v122, v21, v21, v10
    v_perm_b32 v123, v21, v21, v11
    v_perm_b32 v124, v21, v21, v12
    v_perm_b32 v125, v21, v21, v13
    v_perm_b32 v126, v21, v21, v14
    v_perm_b32 v127, v21, v21, v15
    v_perm_b32 v128, v22, v22, v8
    v_perm_b32 v129, v22, v22, v9
    v_perm_b32 v130, v22, v22, v10
    v_perm_b32 v131, v22, v22, v11
    v_perm_b32 v132, v22, v22, v12
    v_perm_b32 v133, v22, v22, v13
    v_perm_b32 v134, v22, v22, v14
    v_perm_b32 v135, v22, v22, v15
    s_waitcnt vmcnt(13)
    v_mfma_f32_16x16x32_bf16 v[136:139], v[80:83], v[24:27], 0
    s_waitcnt vmcnt(12)
    v_mfma_f32_16x16x32_bf16 v[136:139], v[84:87], v[28:31], v[136:139]
    s_waitcnt vmcnt(11)
    v_mfma_f32_16x16x32_bf16 v[136:139], v[88:91], v[32:35], v[136:139]
    s_waitcnt vmcnt(10)
    v_mfma_f32_16x16x32_bf16 v[136:139], v[92:95], v[36:39], v[136:139]
    s_waitcnt vmcnt(9)
    v_mfma_f32_16x16x32_bf16 v[136:139], v[96:99], v[40:43], v[136:139]
    s_waitcnt vmcnt(8)
    v_mfma_f32_16x16x32_bf16 v[136:139], v[100:103], v[44:47], v[136:139]
    s_waitcnt vmcnt(7)
    v_mfma_f32_16x16x32_bf16 v[136:139], v[104:107], v[48:51], v[136:139]
    s_waitcnt vmcnt(6)
    v_mfma_f32_16x16x32_bf16 v[136:139], v[108:111], v[52:55], v[136:139]
    s_waitcnt vmcnt(5)
    v_mfma_f32_16x16x32_bf16 v[136:139], v[112:115], v[56:59], v[136:139]
    s_waitcnt vmcnt(4)
    v_mfma_f32_16x16x32_bf16 v[136:139], v[116:119], v[60:63], v[136:139]
    s_waitcnt vmcnt(3)
    v_mfma_f32_16x16x32_bf16 v[136:139], v[120:123], v[64:67], v[136:139]
    s_waitcnt vmcnt(2)
    v_mfma_f32_16x16x32_bf16 v[136:139], v[124:127], v[68:71], v[136:139]
    s_waitcnt vmcnt(1)
    v_mfma_f32_16x16x32_bf16 v[136:139], v[128:131], v[72:75], v[136:139]
    s_waitcnt vmcnt(0)
    v_mfma_f32_16x16x32_bf16 v[136:139], v[132:135], v[76:79], v[136:139]
    s_cmp_eq_u32 s3, 1
    s_cbranch_scc1 L_h1_post
    s_getreg_b32 s46, hwreg(HW_REG_XCC_ID, 0, 4)
    s_lshl_b32 s35, s4, 13
    s_add_u32 s35, s35, 4096
    s_lshl_b32 s36, s5, 8
    s_add_u32 s36, s36, s35
    v_bfe_u32 v5, v0, 4, 1
    v_lshlrev_b32 v6, 5, v6
    v_lshl_add_u32 v5, v5, 4, v6
    v_add_u32 v144, s36, v5
    s_add_u32 s35, s35, 4096
    v_lshl_add_u32 v4, v0, 4, s35
    s_add_u32 s46, s46, s34
    v_permlane32_swap_b32 v136, v140
    v_permlane32_swap_b32 v137, v141
    v_permlane32_swap_b32 v138, v142
    v_permlane32_swap_b32 v139, v143
    v_add_f32_dpp v136, v140, v136 row_ror:8 row_mask:0xf bank_mask:0xf
    v_add_f32_dpp v137, v141, v137 row_ror:8 row_mask:0xf bank_mask:0xf
    v_add_f32_dpp v138, v142, v138 row_ror:8 row_mask:0xf bank_mask:0xf
    v_add_f32_dpp v139, v143, v139 row_ror:8 row_mask:0xf bank_mask:0xf
    v_lshrrev_b32 v142, 4, v139
    v_and_b32 v138, 0xfffff000, v138
    v_and_or_b32 v142, v142, s44, v138
    v_perm_b32 v140, v136, v139, s42
    v_perm_b32 v141, v137, v139, s43
    v_mov_b32 v143, s46
    s_mov_b64 exec, 0x00ff00ff
    global_store_dwordx4 v144, v[140:143], s[32:33]
    s_mov_b64 exec, -1
    s_mov_b32 s40, 1000000
L_qpoll:
    global_load_dwordx4 v[24:27], v4, s[32:33] offset:-4096 sc1
    global_load_dwordx4 v[28:31], v4, s[32:33] offset:-3072 sc1
    global_load_dwordx4 v[32:35], v4, s[32:33] offset:-2048 sc1
    global_load_dwordx4 v[36:39], v4, s[32:33] offset:-1024 sc1
    global_load_dwordx4 v[40:43], v4, s[32:33] offset:0 sc1
    global_load_dwordx4 v[44:47], v4, s[32:33] offset:1024 sc1
    global_load_dwordx4 v[48:51], v4, s[32:33] offset:2048 sc1
    global_load_dwordx4 v[52:55], v4, s[32:33] offset:3072 sc1
    s_waitcnt vmcnt(0)
    v_or3_b32 v6, v26, v30, v34
    v_or3_b32 v6, v6, v38, v42
    v_or3_b32 v6, v6, v46, v50
    v_or_b32 v6, v6, v54
    v_lshlrev_b32 v6, 24, v6
    v_bitop3_b32 v6, v27, s46, v6 bitop3:0xbe
    v_bitop3_b32 v6, v31, s46, v6 bitop3:0xbe
    v_bitop3_b32 v6, v35, s46, v6 bitop3:0xbe
    v_bitop3_b32 v6, v39, s46, v6 bitop3:0xbe
    v_bitop3_b32 v6, v43, s46, v6 bitop3:0xbe
    v_bitop3_b32 v6, v47, s46, v6 bitop3:0xbe
    v_bitop3_b32 v6, v51, s46, v6 bitop3:0xbe
    v_bitop3_b32 v6, v55, s46, v6 bitop3:0xbe
    v_cmp_lt_u32 vcc, 15, v6
    s_cbranch_vccz L_qpoll_ok
    s_cmp_lg_u32 s40, 999994
    s_cbranch_scc1 L_qpoll_nr
    s_mov_b64 exec, 0x00ff00ff
    global_store_dwordx4 v144, v[140:143], s[32:33] sc1
L_qpoll_nr:
    s_mov_b64 exec, vcc
    s_sub_u32 s40, s40, 1
    s_cbranch_scc0 L_qpoll
L_qpoll_ok:
    s_mov_b64 exec, -1
    v_xor_b32 v6, s46, v27
    v_bitop3_b32 v6, v31, s46, v6 bitop3:0xbe
    v_bitop3_b32 v6, v35, s46, v6 bitop3:0xbe
    v_bitop3_b32 v6, v39, s46, v6 bitop3:0xbe
    v_bitop3_b32 v6, v43, s46, v6 bitop3:0xbe
    v_bitop3_b32 v6, v47, s46, v6 bitop3:0xbe
    v_bitop3_b32 v6, v51, s46, v6 bitop3:0xbe
    v_bitop3_b32 v6, v55, s46, v6 bitop3:0xbe
    v_cmp_ne_u32 vcc, 0, v6
    v_perm_b32 v27, v25, v24, s45
    v_and_b32 v6, s44, v26
    v_lshl_or_b32 v27, v6, 4, v27
    v_perm_b32 v31, v29, v28, s45
    v_and_b32 v6, s44, v30
    v_lshl_or_b32 v31, v6, 4, v31
    v_perm_b32 v35, v33, v32, s45
    v_and_b32 v6, s44, v34
    v_lshl_or_b32 v35, v6, 4, v35
    v_perm_b32 v39, v37, v36, s45
    v_and_b32 v6, s44, v38
    v_lshl_or_b32 v39, v6, 4, v39
    v_perm_b32 v43, v41, v40, s45
    v_and_b32 v6, s44, v42
    v_lshl_or_b32 v43, v6, 4, v43
    v_perm_b32 v47, v45, v44, s45
    v_and_b32 v6, s44, v46
    v_lshl_or_b32 v47, v6, 4, v47
    v_perm_b32 v51, v49, v48, s45
    v_and_b32 v6, s44, v50
    v_lshl_or_b32 v51, v6, 4, v51
    v_perm_b32 v55, v53, v52, s45
    v_and_b32 v6, s44, v54
    v_lshl_or_b32 v55, v6, 4, v55
    s_cmp_eq_u64 vcc, 0
    s_cselect_b32 s47, 2, 1
    s_cbranch_scc1 L_q_local
    s_mov_b64 exec, 0x00ff00ff
    global_store_dwordx4 v144, v[140:143], s[32:33] sc1
    s_mov_b64 exec, -1
L_q_local:
    v_pk_add_f32 v[24:25], v[24:25], v[32:33]
    v_pk_add_f32 v[40:41], v[40:41], v[48:49]
    v_pk_add_f32 v[26:27], v[26:27], v[34:35]
    v_pk_add_f32 v[42:43], v[42:43], v[50:51]
    v_pk_add_f32 v[28:29], v[28:29], v[36:37]
    v_pk_add_f32 v[44:45], v[44:45], v[52:53]
    v_pk_add_f32 v[30:31], v[30:31], v[38:39]
    v_pk_add_f32 v[46:47], v[46:47], v[54:55]
    v_pk_add_f32 v[24:25], v[24:25], v[40:41]
    v_pk_add_f32 v[26:27], v[26:27], v[42:43]
    v_pk_add_f32 v[28:29], v[28:29], v[44:45]
    v_pk_add_f32 v[30:31], v[30:31], v[46:47]
    v_cvt_pk_bf16_f32 v16, v24, v25
    v_cvt_pk_bf16_f32 v17, v26, v27
    v_cvt_pk_bf16_f32 v18, v28, v29
    v_cvt_pk_bf16_f32 v19, v30, v31
    v_lshlrev_b32 v5, 3, v0
    ds_write_b64 v5, v[16:17] offset:0
    ds_write_b64 v5, v[18:19] offset:512
    v_mov_b32 v20, 0
    v_mov_b32 v21, s47
    ds_write_b32 v20, v21 offset:1220
    s_waitcnt lgkmcnt(0)
    s_endpgm
L_h1_nogemv:
    s_barrier
    s_branch L_h1_gate
L_h1_post:
    s_lshl_b32 s35, s58, 12
    s_add_u32 s35, s35, 131072
    s_lshl_b32 s36, s7, 9
    s_add_u32 s36, s36, s35
    v_bfe_u32 v5, v0, 3, 1
    v_bfe_u32 v7, v0, 4, 1
    v_lshl_add_u32 v4, v6, 6, s36
    v_lshl_add_u32 v4, v5, 5, v4
    v_lshl_add_u32 v4, v7, 4, v4
    s_lshl_b32 s36, s7, 6
    s_add_u32 s36, s36, s35
    v_lshl_add_u32 v23, v6, 9, s36
    v_lshl_add_u32 v23, v7, 5, v23
    v_lshl_add_u32 v5, v5, 4, v23
    v_lshrrev_b32 v142, 4, v139
    v_and_b32 v138, 0xfffff000, v138
    v_and_or_b32 v142, v142, s44, v138
    v_perm_b32 v140, v136, v139, s42
    v_perm_b32 v141, v137, v139, s43
    v_mov_b32 v143, s34
    s_mov_b32 exec_hi, 0
    global_store_dwordx4 v4, v[140:143], s[32:33]
    s_mov_b32 exec_hi, -1
L_h1_gate:
    v_lshlrev_b32 v7, 4, v0
    v_mov_b32 v144, 0
    v_mov_b32 v145, 0
    v_mov_b32 v146, 0
    v_mov_b32 v147, 0
    v_mov_b32 v148, 0
    v_mov_b32 v149, 0
    v_mov_b32 v150, 0
    v_mov_b32 v151, 0
    s_mov_b32 exec_hi, 0x00ffffff
    global_load_dwordx4 v[144:147], v7, s[8:9]
    global_load_dwordx4 v[148:151], v7, s[26:27]
    s_mov_b32 exec_hi, -1
    s_mov_b32 s46, 0xffff0000
    s_cmp_eq_u32 s59, 0
    s_cbranch_scc1 L_h1_nopoll
    s_mov_b32 s40, 1000000
L_fpoll:
    global_load_dwordx4 v[32:35], v5, s[32:33] sc1
    s_waitcnt vmcnt(0)
    v_and_b32 v6, 0xff, v34
    v_bitop3_b32 v6, v35, s34, v6 bitop3:0xbe
    v_cmp_ne_u32 vcc, 0, v6
    s_cbranch_vccz L_fpoll_ok
    s_cmp_lg_u32 s40, 999994
    s_cbranch_scc1 L_fpoll_nr
    s_mov_b32 exec_lo, -1
    s_mov_b32 exec_hi, 0
    global_store_dwordx4 v4, v[140:143], s[32:33] sc1
L_fpoll_nr:
    s_mov_b64 exec, vcc
    s_sub_u32 s40, s40, 1
    s_cbranch_scc0 L_fpoll
L_fpoll_ok:
    s_mov_b64 exec, -1
L_h1_nopoll:
    s_waitcnt vmcnt(0)
    v_lshlrev_b32 v16, 16, v144
    v_and_b32 v17, s46, v144
    v_lshlrev_b32 v24, 16, v148
    v_and_b32 v25, s46, v148
    v_lshlrev_b32 v18, 16, v145
    v_and_b32 v19, s46, v145
    v_lshlrev_b32 v26, 16, v149
    v_and_b32 v27, s46, v149
    v_lshlrev_b32 v20, 16, v146
    v_and_b32 v21, s46, v146
    v_lshlrev_b32 v28, 16, v150
    v_and_b32 v29, s46, v150
    v_lshlrev_b32 v22, 16, v147
    v_and_b32 v23, s46, v147
    v_lshlrev_b32 v30, 16, v151
    v_and_b32 v31, s46, v151
    v_mul_f32 v16, v16, v24
    v_mul_f32 v17, v17, v25
    v_mul_f32 v18, v18, v26
    v_mul_f32 v19, v19, v27
    v_mul_f32 v20, v20, v28
    v_mul_f32 v21, v21, v29
    v_mul_f32 v22, v22, v30
    v_mul_f32 v23, v23, v31
    v_cvt_pk_bf16_f32 v24, v16, v17
    v_cvt_pk_bf16_f32 v25, v18, v19
    v_cvt_pk_bf16_f32 v26, v20, v21
    v_cvt_pk_bf16_f32 v27, v22, v23
    v_lshlrev_b32 v16, 16, v24
    v_and_b32 v17, s46, v24
    v_lshlrev_b32 v18, 16, v25
    v_and_b32 v19, s46, v25
    v_lshlrev_b32 v20, 16, v26
    v_and_b32 v21, s46, v26
    v_lshlrev_b32 v22, 16, v27
    v_and_b32 v23, s46, v27
    v_add_f32 v16, v16, v17
    v_add_f32 v18, v18, v19
    v_add_f32 v20, v20, v21
    v_add_f32 v22, v22, v23
    v_add_f32 v16, v16, v18
    v_add_f32 v20, v20, v22
    v_add_f32 v16, v16, v20
    s_nop 1
    v_add_f32_dpp v16, v16, v16 quad_perm:[1,0,3,2] row_mask:0xf bank_mask:0xf
    s_nop 1
    v_add_f32_dpp v16, v16, v16 quad_perm:[2,3,0,1] row_mask:0xf bank_mask:0xf
    s_nop 1
    v_add_f32_dpp v16, v16, v16 row_half_mirror row_mask:0xf bank_mask:0xf
    s_nop 1
    v_add_f32_dpp v16, v16, v16 row_mirror row_mask:0xf bank_mask:0xf
    v_mov_b32 v17, v16
    s_nop 1
    v_permlane32_swap_b32 v17, v16
    v_add_f32 v16, v17, v16
    v_mov_b32 v17, v16
    s_nop 1
    v_permlane16_swap_b32 v17, v16
    v_add_f32 v16, v17, v16
    v_cvt_pk_bf16_f32 v16, v16, v16
    v_and_b32 v16, s46, v16
    v_mul_f32 v16, 0xbfb8aa3b, v16
    v_exp_f32 v16, v16
    s_nop 0
    v_add_f32 v16, 1.0, v16
    v_rcp_f32 v16, v16
    s_nop 0
    v_cvt_pk_bf16_f32 v16, v16, v16
    v_and_b32 v16, s46, v16
    v_sub_f32 v17, 1.0, v16
    v_cvt_pk_bf16_f32 v17, v17, v17
    v_and_b32 v17, s46, v17
    v_mov_b32 v18, 0
    ds_write_b32 v18, v16 offset:1216
    s_cmp_eq_u32 s59, 0
    s_cbranch_scc1 L_h1_done
    v_perm_b32 v35, v33, v32, s45
    v_and_b32 v6, s44, v34
    v_lshl_or_b32 v35, v6, 4, v35
    v_add_f32_dpp v32, v32, v32 quad_perm:[1,0,3,2] row_mask:0xf bank_mask:0xf
    v_add_f32_dpp v33, v33, v33 quad_perm:[1,0,3,2] row_mask:0xf bank_mask:0xf
    v_add_f32_dpp v34, v34, v34 quad_perm:[1,0,3,2] row_mask:0xf bank_mask:0xf
    v_add_f32_dpp v35, v35, v35 quad_perm:[1,0,3,2] row_mask:0xf bank_mask:0xf
    v_add_f32_dpp v32, v32, v32 quad_perm:[2,3,0,1] row_mask:0xf bank_mask:0xf
    v_add_f32_dpp v33, v33, v33 quad_perm:[2,3,0,1] row_mask:0xf bank_mask:0xf
    v_add_f32_dpp v34, v34, v34 quad_perm:[2,3,0,1] row_mask:0xf bank_mask:0xf
    v_add_f32_dpp v35, v35, v35 quad_perm:[2,3,0,1] row_mask:0xf bank_mask:0xf
    v_add_f32_dpp v32, v32, v32 row_half_mirror row_mask:0xf bank_mask:0xf
    v_add_f32_dpp v33, v33, v33 row_half_mirror row_mask:0xf bank_mask:0xf
    v_add_f32_dpp v34, v34, v34 row_half_mirror row_mask:0xf bank_mask:0xf
    v_add_f32_dpp v35, v35, v35 row_half_mirror row_mask:0xf bank_mask:0xf
    v_and_b32 v20, 3, v0
    v_cmp_eq_u32 s[50:51], 1, v20
    v_cmp_eq_u32 s[52:53], 2, v20
    v_cmp_eq_u32 vcc, 3, v20
    v_cndmask_b32 v24, v32, v33, s[50:51]
    v_cndmask_b32 v24, v24, v34, s[52:53]
    v_cndmask_b32 v24, v24, v35, vcc
    v_cvt_pk_bf16_f32 v24, v24, v24
    v_and_b32 v24, s46, v24
    v_mov_b32 v25, v24
    s_nop 1
    v_permlane16_swap_b32 v24, v25
    v_mul_f32 v26, 0xbfb8aa3b, v24
    v_exp_f32 v26, v26
    s_nop 0
    v_add_f32 v26, 1.0, v26
    v_rcp_f32 v26, v26
    s_nop 0
    v_mul_f32 v26, v26, v24
    v_cvt_pk_bf16_f32 v26, v26, v26
    v_and_b32 v26, s46, v26
    v_mul_f32 v26, v26, v25
    v_cvt_pk_bf16_f32 v26, v26, v26
    v_and_b32 v26, s46, v26
    v_mul_f32 v26, v26, v17
    v_cvt_pk_bf16_f32 v26, v26, v26
    v_bfe_u32 v21, v0, 3, 1
    v_lshl_add_u32 v21, v21, 2, v20
    v_lshlrev_b32 v21, 2, v21
    s_mov_b64 exec, 0xffff
    ds_write_b32 v21, v26 offset:1184
    s_mov_b32 s40, 8000000
L_fspin:
    ds_read_b32 v19, v18 offset:1220
    s_waitcnt lgkmcnt(0)
    v_readfirstlane_b32 s49, v19
    s_sub_u32 s40, s40, 1
    s_cselect_b32 s49, 1, s49
    s_cmp_eq_u32 s49, 0
    s_cbranch_scc1 L_fspin
    s_cmp_eq_u32 s49, 2
    s_cbranch_scc1 L_h1_done
    s_mov_b32 exec_lo, -1
    s_mov_b32 exec_hi, 0
    global_store_dwordx4 v4, v[140:143], s[32:33] sc1
L_h1_done:
    s_waitcnt lgkmcnt(0)
    s_endpgm
L_stream:
    s_sub_u32 s6, s3, 2
    s_lshl_b32 s35, s4, 25
    s_lshl_b32 s36, s5, 16
    s_lshl_b32 s37, s6, 13
    s_add_u32 s35, s35, s36
    s_add_u32 s35, s35, s37
    s_add_u32 s35, s35, 31461376
    v_lshrrev_b32 v4, 4, v0
    v_bfe_u32 v5, v0, 2, 2
    v_and_b32 v6, 3, v0
    v_and_b32 v7, 15, v0
    v_lshl_add_u32 v2, v5, 9, s35
    v_lshl_add_u32 v3, v4, 9, s35
    v_lshl_add_u32 v2, v4, 6, v2
    v_lshl_add_u32 v3, v7, 4, v3
    v_lshl_add_u32 v2, v6, 4, v2
    v_bfe_u32 v80, v0, 2, 1
    v_bfe_u32 v82, v0, 4, 1
    v_lshrrev_b32 v83, 5, v0
    s_and_b32 s36, s6, 3
    s_lshl_b32 s36, s36, 16
    s_lshl_b32 s37, s4, 12
    s_add_u32 s36, s36, s37
    s_lshl_b32 s37, s5, 7
    s_add_u32 s36, s36, s37
    s_add_u32 s36, s36, 1310720
    v_lshl_add_u32 v153, v80, 15, s36
    v_lshl_add_u32 v81, v6, 1, v82
    v_lshl_add_u32 v153, v83, 18, v153
    v_lshl_add_u32 v153, v81, 4, v153
    s_mov_b32 s56, 0x00ff00ff
    s_cmp_eq_u32 s6, 3
    s_cselect_b32 s57, 0, s56
    s_cmp_lt_u32 s6, 4
    s_waitcnt lgkmcnt(0)
    s_cbranch_scc0 L_noprew
    s_mov_b64 exec, s[56:57]
    global_load_dword v161, v153, s[32:33]
    s_mov_b64 exec, -1
L_noprew:
    s_load_dword s34, s[32:33], 12
    s_barrier
    global_load_dwordx4 v[16:19], v2, s[10:11] offset:-4096 nt
    global_load_dwordx4 v[20:23], v2, s[10:11] offset:-3840 nt
    global_load_dwordx4 v[24:27], v2, s[10:11] offset:-2048 nt
    global_load_dwordx4 v[28:31], v2, s[10:11] offset:-1792 nt
    v_and_b32 v1, 1, v0
    v_bfe_u32 v15, v0, 1, 2
    v_mov_b32 v8, 0x0c0c0100
    v_mov_b32 v9, 0x01000c0c
    v_cmp_eq_u32 vcc, 1, v1
    v_mov_b32 v10, 0x0c0c0302
    v_mov_b32 v11, 0x03020c0c
    v_cndmask_b32 v1, v8, v9, vcc
    v_cndmask_b32 v14, v10, v11, vcc
    v_cmp_eq_u32 s[50:51], 0, v15
    v_cmp_eq_u32 s[52:53], 1, v15
    v_cmp_eq_u32 s[54:55], 2, v15
    v_cmp_eq_u32 vcc, 3, v15
    v_mov_b32 v15, 0x0c0c0c0c
    v_cndmask_b32 v8, v15, v1, s[50:51]
    v_cndmask_b32 v9, v15, v1, s[52:53]
    v_cndmask_b32 v10, v15, v1, s[54:55]
    v_cndmask_b32 v11, v15, v1, vcc
    v_cndmask_b32 v12, v15, v14, s[50:51]
    v_cndmask_b32 v13, v15, v14, s[52:53]
    v_cndmask_b32 v1, v15, v14, s[54:55]
    v_cndmask_b32 v15, v15, v14, vcc
    v_mov_b32 v14, v1
    s_and_b32 s36, s6, 3
    s_lshl_b32 s36, s36, 7
    s_lshl_b32 s37, s4, 5
    s_add_u32 s37, s37, s5
    s_mul_i32 s38, s37, 14336
    s_add_u32 s38, s38, s36
    s_lshl_b32 s39, s58, 3
    s_add_u32 s39, s39, s7
    s_mul_i32 s39, s39, 7168
    s_add_u32 s39, s39, s36
    v_lshrrev_b32 v92, 3, v0
    v_and_b32 v93, 7, v0
    v_lshlrev_b32 v93, 4, v93
    v_mul_u32_u24 v81, 896, v92
    s_sub_u32 s46, 0, s59
    s_cmp_eq_u32 s6, 3
    s_cselect_b32 s44, 0, -1
    s_cselect_b32 s45, 0, 512
    s_and_b32 s47, s44, s46
    v_add3_u32 v80, v81, v81, v93
    v_add_u32 v81, v81, v93
    v_and_b32 v156, s44, v80
    v_and_b32 v157, s47, v81
    v_and_b32 v81, s46, v81
    v_add_u32 v80, s38, v80
    v_add_u32 v81, s39, v81
    s_add_u32 s38, s38, s45
    s_add_u32 s39, s39, s45
    v_add_u32 v156, s38, v156
    v_add_u32 v157, s39, v157
    v_bfe_u32 v94, v0, 3, 1
    v_lshlrev_b32 v164, 9, v94
    v_lshl_add_u32 v164, v4, 6, v164
    v_lshl_add_u32 v164, v6, 4, v164
    s_lshl_b32 s36, s6, 3
    v_lshl_add_u32 v95, v94, 6, s36
    v_lshl_add_u32 v94, v83, 6, s36
    v_lshrrev_b32 v5, 1, v93
    v_lshl_add_u32 v165, v83, 6, v5
    v_lshlrev_b32 v92, 2, v92
    s_lshl_b32 s36, s6, 11
    s_cmp_eq_u32 s6, 7
    s_cselect_b32 s36, 0, s36
    v_lshl_add_u32 v166, v0, 4, s36
    s_lshl_b32 s37, s37, 11
    s_add_u32 s37, s37, 262144
    v_lshl_add_u32 v167, v7, 6, s37
    v_lshl_add_u32 v167, v4, 4, v167
    s_lshl_b32 s36, s6, 9
    s_add_u32 s36, s36, s37
    v_lshl_add_u32 v158, v6, 7, s36
    s_lshl_b32 s42, s4, 16
    s_lshl_b32 s43, s5, 6
    s_add_u32 s42, s42, s43
    s_add_u32 s42, s42, 262144
    v_lshl_add_u32 v152, v83, 15, s42
    v_lshrrev_b32 v5, 1, v7
    v_lshl_add_u32 v152, v5, 11, v152
    v_and_b32 v5, 1, v0
    v_lshl_add_u32 v5, v5, 1, v82
    v_lshl_add_u32 v152, v5, 4, v152
    v_add_u32 v82, 0x4000, v152
    s_cmp_eq_u32 s4, 5
    s_cselect_b32 s61, s5, 99
    s_mov_b32 s50, 0x07060500
    s_mov_b32 s51, 0x07060501
    s_mov_b32 s53, 0x04000c0c
    s_movk_i32 s55, 0xff
    s_mov_b32 s54, 0xffff0000
    s_mov_b32 s48, 1035512379
    v_mov_b32 v1, 0
    s_waitcnt lgkmcnt(0)
    s_lshr_b32 s42, s61, 1
    s_lshl_b32 s42, s42, 15
    s_lshl_b32 s43, s6, 12
    s_add_u32 s42, s42, s43
    s_and_b32 s43, s61, 1
    s_lshl_b32 s43, s43, 6
    s_add_u32 s42, s42, s43
    s_add_u32 s42, s42, 1310720
    v_lshrrev_b32 v5, 2, v0
    v_lshl_add_u32 v154, v5, 7, s42
    v_lshl_add_u32 v154, v6, 4, v154
    v_lshrrev_b32 v5, 4, v0
    s_lshl_b32 s36, s61, 5
    v_lshl_add_u32 v4, v5, 1, s36
    v_lshl_add_u32 v4, v6, 3, v4
    v_lshl_add_u32 v7, v5, 2, v6
    v_mul_u32_u24 v7, 48, v7
    s_lshl_b32 s43, s6, 2
    v_add_u32 v155, s43, v7
    s_and_b32 s34, s34, -16
    s_add_u32 s34, s34, 16
    s_max_u32 s34, s34, 16
    v_mov_b32 v159, s34
    v_mov_b32 v163, s34
    s_waitcnt vmcnt(3)
    global_load_dwordx4 v[32:35], v2, s[10:11] offset:0 nt
    s_waitcnt vmcnt(3)
    global_load_dwordx4 v[36:39], v2, s[10:11] offset:256 nt
    s_waitcnt vmcnt(3)
    global_load_dwordx4 v[40:43], v2, s[10:11] offset:2048 nt
    s_waitcnt vmcnt(3)
    global_load_dwordx4 v[44:47], v2, s[10:11] offset:2304 nt
    s_waitcnt vmcnt(3)
    global_load_dwordx4 v[48:51], v3, s[12:13] offset:-4096 nt
    s_waitcnt vmcnt(3)
    global_load_dwordx4 v[52:55], v3, s[12:13] offset:-3840 nt
    s_waitcnt vmcnt(3)
    global_load_dwordx4 v[56:59], v3, s[12:13] offset:-2048 nt
    s_waitcnt vmcnt(3)
    global_load_dwordx4 v[60:63], v3, s[12:13] offset:-1792 nt
    global_load_dwordx4 v[64:67], v3, s[12:13] offset:0 nt
    global_load_dwordx4 v[68:71], v3, s[12:13] offset:256 nt
    global_load_dwordx4 v[72:75], v3, s[12:13] offset:2048 nt
    global_load_dwordx4 v[76:79], v3, s[12:13] offset:2304 nt
    s_mov_b32 s40, 8000000
L_qspin:
    ds_read_b32 v112, v1 offset:1220
    s_waitcnt lgkmcnt(0)
    v_readfirstlane_b32 s49, v112
    s_sub_u32 s40, s40, 1
    s_cselect_b32 s49, 1, s49
    s_cmp_eq_u32 s49, 0
    s_cbranch_scc1 L_qspin
    ds_read_b128 v[84:87], v164 offset:0
    ds_read_b128 v[88:91], v164 offset:256
    s_waitcnt lgkmcnt(1)
    v_mfma_f32_16x16x32_bf16 v[96:99], v[16:19], v[84:87], 0
    v_mfma_f32_16x16x32_bf16 v[100:103], v[24:27], v[84:87], 0
    v_mfma_f32_16x16x32_bf16 v[104:107], v[32:35], v[84:87], 0
    v_mfma_f32_16x16x32_bf16 v[108:111], v[40:43], v[84:87], 0
    s_waitcnt lgkmcnt(0)
    v_mfma_f32_16x16x32_bf16 v[96:99], v[20:23], v[88:91], v[96:99]
    v_mfma_f32_16x16x32_bf16 v[100:103], v[28:31], v[88:91], v[100:103]
    v_mfma_f32_16x16x32_bf16 v[104:107], v[36:39], v[88:91], v[104:107]
    v_mfma_f32_16x16x32_bf16 v[108:111], v[44:47], v[88:91], v[108:111]
    s_nop 4
    v_mov_b32_dpp v112, v96 quad_perm:[0,0,0,0] row_mask:0xf bank_mask:0xf
    v_mov_b32_dpp v113, v100 quad_perm:[0,0,0,0] row_mask:0xf bank_mask:0xf
    v_mov_b32_dpp v114, v104 quad_perm:[0,0,0,0] row_mask:0xf bank_mask:0xf
    v_mov_b32_dpp v115, v108 quad_perm:[0,0,0,0] row_mask:0xf bank_mask:0xf
    v_add_f32_dpp v112, v97, v112 quad_perm:[1,1,1,1] row_mask:0xf bank_mask:0xf
    v_add_f32_dpp v113, v101, v113 quad_perm:[1,1,1,1] row_mask:0xf bank_mask:0xf
    v_add_f32_dpp v114, v105, v114 quad_perm:[1,1,1,1] row_mask:0xf bank_mask:0xf
    v_add_f32_dpp v115, v109, v115 quad_perm:[1,1,1,1] row_mask:0xf bank_mask:0xf
    v_add_f32_dpp v112, v98, v112 quad_perm:[2,2,2,2] row_mask:0xf bank_mask:0xf
    v_add_f32_dpp v113, v102, v113 quad_perm:[2,2,2,2] row_mask:0xf bank_mask:0xf
    v_add_f32_dpp v114, v106, v114 quad_perm:[2,2,2,2] row_mask:0xf bank_mask:0xf
    v_add_f32_dpp v115, v110, v115 quad_perm:[2,2,2,2] row_mask:0xf bank_mask:0xf
    v_add_f32_dpp v112, v99, v112 quad_perm:[3,3,3,3] row_mask:0xf bank_mask:0xf
    v_add_f32_dpp v113, v103, v113 quad_perm:[3,3,3,3] row_mask:0xf bank_mask:0xf
    v_add_f32_dpp v114, v107, v114 quad_perm:[3,3,3,3] row_mask:0xf bank_mask:0xf
    v_add_f32_dpp v115, v111, v115 quad_perm:[3,3,3,3] row_mask:0xf bank_mask:0xf
    v_max3_f32 v96, v112, v113, v114
    v_max_f32 v96, v96, v115
    v_mov_b32 v97, v96
    s_nop 1
    v_permlane32_swap_b32 v97, v96
    v_max_f32 v96, v97, v96
    v_mov_b32 v97, v96
    s_nop 1
    v_permlane16_swap_b32 v97, v96
    v_max_f32 v96, v97, v96
    v_mul_f32 v96, s48, v96
    v_fma_f32 v112, v112, s48, -v96
    v_fma_f32 v113, v113, s48, -v96
    v_fma_f32 v114, v114, s48, -v96
    v_fma_f32 v115, v115, s48, -v96
    v_exp_f32 v112, v112
    v_exp_f32 v113, v113
    v_exp_f32 v114, v114
    v_exp_f32 v115, v115
    v_add_f32 v97, v112, v113
    v_add_f32 v98, v114, v115
    v_add_f32 v97, v97, v98
    v_mov_b32 v98, v97
    s_nop 1
    v_permlane32_swap_b32 v98, v97
    v_add_f32 v97, v98, v97
    v_mov_b32 v98, v97
    s_nop 1
    v_permlane16_swap_b32 v98, v97
    v_add_f32 v97, v98, v97
    ds_write_b64 v95, v[96:97] offset:1024
    v_cvt_pk_bf16_f32 v112, v112, v112
    v_cvt_pk_bf16_f32 v113, v113, v113
    v_cvt_pk_bf16_f32 v114, v114, v114
    v_cvt_pk_bf16_f32 v115, v115, v115
    v_perm_b32 v128, v112, v112, v8
    v_perm_b32 v129, v112, v112, v9
    v_perm_b32 v130, v112, v112, v10
    v_perm_b32 v131, v112, v112, v11
    v_perm_b32 v132, v113, v113, v8
    v_perm_b32 v133, v113, v113, v9
    v_perm_b32 v134, v113, v113, v10
    v_perm_b32 v135, v113, v113, v11
    v_perm_b32 v136, v114, v114, v8
    v_perm_b32 v137, v114, v114, v9
    v_perm_b32 v138, v114, v114, v10
    v_perm_b32 v139, v114, v114, v11
    v_perm_b32 v140, v115, v115, v8
    v_perm_b32 v141, v115, v115, v9
    v_perm_b32 v142, v115, v115, v10
    v_perm_b32 v143, v115, v115, v11
    s_mov_b32 s40, 1000000
    s_waitcnt lgkmcnt(0)
    s_barrier
    s_cmp_eq_u32 s4, 5
    s_cselect_b32 s62, s49, 0
    ds_read_b64 v[100:101], v165 offset:1024
    ds_read_b32 v102, v94 offset:1024
    ds_read_b32 v109, v1 offset:1216
    ds_read_b32 v108, v92 offset:1184
    s_waitcnt lgkmcnt(3)
    v_max_f32_dpp v103, v100, v100 quad_perm:[1,0,3,2] row_mask:0xf bank_mask:0xf
    s_nop 1
    v_max_f32_dpp v103, v103, v103 quad_perm:[2,3,0,1] row_mask:0xf bank_mask:0xf
    s_nop 1
    v_max_f32_dpp v103, v103, v103 row_half_mirror row_mask:0xf bank_mask:0xf
    v_sub_f32 v100, v100, v103
    s_waitcnt lgkmcnt(2)
    v_sub_f32 v102, v102, v103
    v_exp_f32 v100, v100
    v_exp_f32 v102, v102
    v_mul_f32 v100, v100, v101
    s_nop 1
    v_add_f32_dpp v100, v100, v100 quad_perm:[1,0,3,2] row_mask:0xf bank_mask:0xf
    s_waitcnt lgkmcnt(0)
    v_mul_f32 v102, v102, v109
    v_add_f32_dpp v100, v100, v100 quad_perm:[2,3,0,1] row_mask:0xf bank_mask:0xf
    v_perm_b32 v104, v108, v108, v8
    v_perm_b32 v105, v108, v108, v9
    v_add_f32_dpp v100, v100, v100 row_half_mirror row_mask:0xf bank_mask:0xf
    v_perm_b32 v106, v108, v108, v10
    v_perm_b32 v107, v108, v108, v11
    v_rcp_f32 v101, v100
    v_log_f32 v100, v100
    v_mul_f32 v102, v102, v101
    v_add_f32 v100, v100, v103
    v_mov_b32 v103, v102
    s_cmp_eq_u32 s6, 7
    s_cbranch_scc1 L_w7
    s_cmp_ge_u32 s6, 4
    s_cbranch_scc1 L_pv_b
    global_load_dword v161, v158, s[32:33] sc1
    s_waitcnt vmcnt(8)
    v_mfma_f32_16x16x32_bf16 v[144:147], v[128:131], v[48:51], 0
    s_waitcnt vmcnt(7)
    v_mfma_f32_16x16x32_bf16 v[148:151], v[128:131], v[52:55], 0
    s_waitcnt vmcnt(6)
    v_mfma_f32_16x16x32_bf16 v[144:147], v[132:135], v[56:59], v[144:147]
    s_waitcnt vmcnt(5)
    v_mfma_f32_16x16x32_bf16 v[148:151], v[132:135], v[60:63], v[148:151]
    s_waitcnt vmcnt(4)
    v_mfma_f32_16x16x32_bf16 v[144:147], v[136:139], v[64:67], v[144:147]
    s_waitcnt vmcnt(3)
    v_mfma_f32_16x16x32_bf16 v[148:151], v[136:139], v[68:71], v[148:151]
    global_load_dwordx4 v[116:119], v80, s[16:17] nt
    global_load_dwordx4 v[120:123], v80, s[16:17] offset:896 nt
    s_waitcnt vmcnt(4)
    v_mfma_f32_16x16x32_bf16 v[144:147], v[140:143], v[72:75], v[144:147]
    global_load_dwordx4 v[16:19], v156, s[16:17] nt
    global_load_dwordx4 v[20:23], v156, s[16:17] offset:896 nt
    s_waitcnt vmcnt(5)
    v_mfma_f32_16x16x32_bf16 v[148:151], v[140:143], v[76:79], v[148:151]
    global_load_dwordx4 v[124:127], v81, s[24:25] nt
    global_load_dwordx4 v[24:27], v157, s[24:25] nt
    s_branch L_pv_done
L_pv_b:
    s_barrier
    s_waitcnt vmcnt(7)
    v_mfma_f32_16x16x32_bf16 v[144:147], v[128:131], v[48:51], 0
    s_waitcnt vmcnt(6)
    v_mfma_f32_16x16x32_bf16 v[148:151], v[128:131], v[52:55], 0
    s_waitcnt vmcnt(5)
    v_mfma_f32_16x16x32_bf16 v[144:147], v[132:135], v[56:59], v[144:147]
    s_waitcnt vmcnt(4)
    v_mfma_f32_16x16x32_bf16 v[148:151], v[132:135], v[60:63], v[148:151]
    s_waitcnt vmcnt(3)
    v_mfma_f32_16x16x32_bf16 v[144:147], v[136:139], v[64:67], v[144:147]
    s_waitcnt vmcnt(2)
    v_mfma_f32_16x16x32_bf16 v[148:151], v[136:139], v[68:71], v[148:151]
    s_waitcnt vmcnt(1)
    v_mfma_f32_16x16x32_bf16 v[144:147], v[140:143], v[72:75], v[144:147]
    s_waitcnt vmcnt(0)
    v_mfma_f32_16x16x32_bf16 v[148:151], v[140:143], v[76:79], v[148:151]
L_pv_done:
    s_nop 5
    v_pk_mul_f32 v[144:145], v[144:145], v[102:103]
    v_pk_mul_f32 v[146:147], v[146:147], v[102:103]
    ds_write_b128 v166, v[144:147] offset:3072
    v_pk_mul_f32 v[148:149], v[148:149], v[102:103]
    v_pk_mul_f32 v[150:151], v[150:151], v[102:103]
    s_cmp_lt_u32 s6, 4
    ds_write_b128 v166, v[148:151] offset:4096
    s_waitcnt lgkmcnt(0)
    s_barrier
    s_cbranch_scc1 L_proj
    s_cmp_ge_u32 s61, 28
    s_cbranch_scc1 L_s_exit2
    s_barrier
    s_branch L_ywait
L_w7:
    v_and_b32 v158, 0xffffff00, v100
    v_and_b32 v162, 0xffffff00, v100
    s_barrier
    ds_read_b128 v[16:19], v166 offset:3072
    ds_read_b128 v[44:47], v166 offset:4096
    ds_read_b128 v[20:23], v166 offset:5120
    ds_read_b128 v[116:119], v166 offset:6144
    ds_read_b128 v[24:27], v166 offset:7168
    ds_read_b128 v[120:123], v166 offset:8192
    ds_read_b128 v[28:31], v166 offset:9216
    ds_read_b128 v[124:127], v166 offset:10240
    s_waitcnt lgkmcnt(4)
    v_pk_add_f32 v[16:17], v[16:17], v[20:21]
    v_pk_add_f32 v[18:19], v[18:19], v[22:23]
    v_pk_add_f32 v[44:45], v[44:45], v[116:117]
    v_pk_add_f32 v[46:47], v[46:47], v[118:119]
    s_waitcnt lgkmcnt(2)
    v_pk_add_f32 v[16:17], v[16:17], v[24:25]
    v_pk_add_f32 v[18:19], v[18:19], v[26:27]
    v_pk_add_f32 v[44:45], v[44:45], v[120:121]
    v_pk_add_f32 v[46:47], v[46:47], v[122:123]
    s_waitcnt lgkmcnt(0)
    v_pk_add_f32 v[16:17], v[16:17], v[28:29]
    v_pk_add_f32 v[18:19], v[18:19], v[30:31]
    v_pk_add_f32 v[44:45], v[44:45], v[124:125]
    v_pk_add_f32 v[46:47], v[46:47], v[126:127]
    s_barrier
    ds_read_b128 v[32:35], v166 offset:11264
    ds_read_b128 v[88:91], v166 offset:12288
    ds_read_b128 v[36:39], v166 offset:13312
    ds_read_b128 v[96:99], v166 offset:14336
    ds_read_b128 v[40:43], v166 offset:15360
    ds_read_b128 v[84:87], v166 offset:16384
    s_cmp_lg_u32 s49, 2
    s_waitcnt lgkmcnt(4)
    v_pk_add_f32 v[16:17], v[16:17], v[32:33]
    v_pk_add_f32 v[18:19], v[18:19], v[34:35]
    v_pk_add_f32 v[44:45], v[44:45], v[88:89]
    v_pk_add_f32 v[46:47], v[46:47], v[90:91]
    s_waitcnt lgkmcnt(2)
    v_pk_add_f32 v[16:17], v[16:17], v[36:37]
    v_pk_add_f32 v[18:19], v[18:19], v[38:39]
    v_pk_add_f32 v[44:45], v[44:45], v[96:97]
    v_pk_add_f32 v[46:47], v[46:47], v[98:99]
    s_waitcnt lgkmcnt(0)
    v_pk_add_f32 v[16:17], v[16:17], v[40:41]
    v_pk_add_f32 v[18:19], v[18:19], v[42:43]
    v_pk_add_f32 v[44:45], v[44:45], v[84:85]
    v_pk_add_f32 v[46:47], v[46:47], v[86:87]
    s_waitcnt vmcnt(7)
    v_mfma_f32_16x16x32_bf16 v[144:147], v[128:131], v[48:51], 0
    s_waitcnt vmcnt(6)
    v_mfma_f32_16x16x32_bf16 v[148:151], v[128:131], v[52:55], 0
    s_waitcnt vmcnt(5)
    v_mfma_f32_16x16x32_bf16 v[144:147], v[132:135], v[56:59], v[144:147]
    s_waitcnt vmcnt(4)
    v_mfma_f32_16x16x32_bf16 v[148:151], v[132:135], v[60:63], v[148:151]
    s_waitcnt vmcnt(3)
    v_mfma_f32_16x16x32_bf16 v[144:147], v[136:139], v[64:67], v[144:147]
    s_waitcnt vmcnt(2)
    v_mfma_f32_16x16x32_bf16 v[148:151], v[136:139], v[68:71], v[148:151]
    s_waitcnt vmcnt(1)
    v_mfma_f32_16x16x32_bf16 v[144:147], v[140:143], v[72:75], v[144:147]
    s_waitcnt vmcnt(0)
    v_mfma_f32_16x16x32_bf16 v[148:151], v[140:143], v[76:79], v[148:151]
    s_nop 5
    v_pk_fma_f32 v[144:145], v[144:145], v[102:103], v[16:17]
    v_pk_fma_f32 v[146:147], v[146:147], v[102:103], v[18:19]
    v_cvt_pk_bf16_f32 v156, v144, v145
    v_cvt_pk_bf16_f32 v157, v146, v147
    s_cbranch_scc1 L_pubfar
    global_store_dwordx4 v152, v[156:159], s[32:33]
    v_pk_fma_f32 v[148:149], v[148:149], v[102:103], v[44:45]
    v_pk_fma_f32 v[150:151], v[150:151], v[102:103], v[46:47]
    v_cvt_pk_bf16_f32 v160, v148, v149
    v_cvt_pk_bf16_f32 v161, v150, v151
    global_store_dwordx4 v82, v[160:163], s[32:33]
L_pubdone:
    s_barrier
    s_cmp_ge_u32 s61, 28
    s_cbranch_scc1 L_s_exit
    s_branch L_ywait
L_pubfar:
    global_store_dwordx4 v152, v[156:159], s[32:33] sc1
    s_nop 1
    v_pk_fma_f32 v[148:149], v[148:149], v[102:103], v[44:45]
    v_pk_fma_f32 v[150:151], v[150:151], v[102:103], v[46:47]
    v_cvt_pk_bf16_f32 v160, v148, v149
    v_cvt_pk_bf16_f32 v161, v150, v151
    global_store_dwordx4 v82, v[160:163], s[32:33] sc1
    s_branch L_pubdone
L_proj:
    s_barrier
    s_barrier
    s_cmp_lg_u32 s59, 0
    s_waitcnt vmcnt(0)
    s_cbranch_scc1 L_dowd
    v_mov_b32 v144, 0
    v_mov_b32 v145, 0
    v_mov_b32 v146, 0
    v_mov_b32 v147, 0
    v_mov_b32 v148, 0
    v_mov_b32 v149, 0
    v_mov_b32 v150, 0
    v_mov_b32 v151, 0
    s_branch L_wddone
L_dowd:
    v_mfma_f32_16x16x32_bf16 v[144:147], v[104:107], v[124:127], 0
    v_mfma_f32_16x16x32_bf16 v[148:151], v[104:107], v[24:27], 0
L_wddone:
L_opoll:
    global_load_dwordx4 v[32:35], v167, s[32:33] offset:0 sc1
    global_load_dwordx4 v[36:39], v167, s[32:33] offset:1024 sc1
    s_waitcnt vmcnt(0)
    v_bitop3_b32 v6, v34, v38, s55 bitop3:0xa8
    v_bitop3_b32 v6, v35, s34, v6 bitop3:0xbe
    v_bitop3_b32 v6, v39, s34, v6 bitop3:0xbe
    v_cmp_ne_u32 vcc, 0, v6
    s_cbranch_vccz L_opoll_ok
    s_mov_b64 exec, vcc
    s_sub_u32 s40, s40, 1
    s_cbranch_scc0 L_opoll
L_opoll_ok:
    s_mov_b64 exec, -1
    v_max_f32 v28, v34, v38
    v_lshlrev_b32 v40, 16, v32
    v_and_b32 v41, s54, v32
    v_max_f32_dpp v28, v28, v28 quad_perm:[1,0,3,2] row_mask:0xf bank_mask:0xf
    v_lshlrev_b32 v42, 16, v33
    v_and_b32 v43, s54, v33
    v_max_f32_dpp v28, v28, v28 quad_perm:[2,3,0,1] row_mask:0xf bank_mask:0xf
    v_lshlrev_b32 v44, 16, v36
    v_and_b32 v45, s54, v36
    v_max_f32_dpp v28, v28, v28 row_half_mirror row_mask:0xf bank_mask:0xf
    v_lshlrev_b32 v46, 16, v37
    v_and_b32 v47, s54, v37
    v_max_f32_dpp v28, v28, v28 row_mirror row_mask:0xf bank_mask:0xf
    v_sub_f32 v34, v34, v28
    v_sub_f32 v38, v38, v28
    v_exp_f32 v34, v34
    v_exp_f32 v38, v38
    v_pk_mul_f32 v[40:41], v[40:41], v[34:35] op_sel_hi:[1,0]
    v_pk_mul_f32 v[42:43], v[42:43], v[34:35] op_sel_hi:[1,0]
    v_add_f32 v29, v34, v38
    v_pk_fma_f32 v[40:41], v[44:45], v[38:39], v[40:41] op_sel_hi:[1,0,1]
    v_pk_fma_f32 v[42:43], v[46:47], v[38:39], v[42:43] op_sel_hi:[1,0,1]
    v_add_f32_dpp v29, v29, v29 row_ror:8 row_mask:0xf bank_mask:0xf
    v_add_f32_dpp v30, v40, v40 row_ror:8 row_mask:0xf bank_mask:0x3
    v_add_f32_dpp v31, v41, v41 row_ror:8 row_mask:0xf bank_mask:0x3
    v_add_f32_dpp v29, v29, v29 row_half_mirror row_mask:0xf bank_mask:0xf
    v_add_f32_dpp v30, v42, v42 row_ror:8 row_mask:0xf bank_mask:0xc
    v_add_f32_dpp v31, v43, v43 row_ror:8 row_mask:0xf bank_mask:0xc
    v_add_f32_dpp v29, v29, v29 quad_perm:[1,0,3,2] row_mask:0xf bank_mask:0xf
    v_add_f32_dpp v30, v30, v30 row_half_mirror row_mask:0xf bank_mask:0xf
    v_add_f32_dpp v31, v31, v31 row_half_mirror row_mask:0xf bank_mask:0xf
    v_add_f32_dpp v29, v29, v29 quad_perm:[2,3,0,1] row_mask:0xf bank_mask:0xf
    v_add_f32_dpp v30, v30, v30 quad_perm:[1,0,3,2] row_mask:0xf bank_mask:0xf
    v_add_f32_dpp v31, v31, v31 quad_perm:[1,0,3,2] row_mask:0xf bank_mask:0xf
    v_rcp_f32 v29, v29
    v_add_f32_dpp v30, v30, v30 quad_perm:[2,3,0,1] row_mask:0xf bank_mask:0xf
    v_add_f32_dpp v31, v31, v31 quad_perm:[2,3,0,1] row_mask:0xf bank_mask:0xf
    s_cmp_eq_u32 s62, 2
    v_pk_mul_f32 v[30:31], v[30:31], v[28:29] op_sel:[0,1] op_sel_hi:[1,1]
    s_nop 0
    v_cvt_pk_bf16_f32 v108, v30, v31
    v_perm_b32 v128, v108, v108, v8
    v_perm_b32 v129, v108, v108, v9
    v_perm_b32 v130, v108, v108, v10
    v_perm_b32 v131, v108, v108, v11
    v_perm_b32 v132, v108, v108, v12
    v_perm_b32 v133, v108, v108, v13
    v_mfma_f32_16x16x32_bf16 v[144:147], v[128:131], v[116:119], v[144:147]
    v_perm_b32 v134, v108, v108, v14
    v_perm_b32 v135, v108, v108, v15
    v_mfma_f32_16x16x32_bf16 v[148:151], v[128:131], v[16:19], v[148:151]
    s_nop 0
    v_mfma_f32_16x16x32_bf16 v[144:147], v[132:135], v[120:123], v[144:147]
    v_mfma_f32_16x16x32_bf16 v[148:151], v[132:135], v[20:23], v[148:151]
    s_nop 7
    v_permlane32_swap_b32 v147, v151
    v_permlane32_swap_b32 v144, v148
    v_permlane32_swap_b32 v145, v149
    v_permlane32_swap_b32 v146, v150
    v_add_f32_dpp v147, v151, v147 row_ror:8 row_mask:0xf bank_mask:0xf
    v_add_f32_dpp v144, v148, v144 row_ror:8 row_mask:0xf bank_mask:0xf
    v_add_f32_dpp v145, v149, v145 row_ror:8 row_mask:0xf bank_mask:0xf
    v_add_f32_dpp v146, v150, v146 row_ror:8 row_mask:0xf bank_mask:0xf
    v_cvt_pk_bf16_f32 v147, v147, v147
    v_and_b32 v162, 0xffffff00, v146
    v_perm_b32 v160, v144, v147, s50
    v_perm_b32 v161, v145, v147, s51
    s_mov_b64 exec, s[56:57]
    s_cbranch_scc1 L_yloc
    global_store_dwordx4 v153, v[160:163], s[32:33] sc1
    s_branch L_ydone
L_yloc:
    global_store_dwordx4 v153, v[160:163], s[32:33]
L_ydone:
    s_cmp_ge_u32 s61, 28
    s_cbranch_scc1 L_s_exit
    s_mov_b64 exec, -1
    s_mov_b32 s40, 1000000
L_ywait:
    s_waitcnt vmcnt(0)
    s_barrier
L_ypoll:
    global_load_dwordx4 v[24:27], v154, s[32:33] offset:0 sc1
    global_load_dwordx4 v[28:31], v154, s[32:33] offset:2048 sc1
    s_waitcnt vmcnt(0)
    v_bitop3_b32 v6, v26, v30, s55 bitop3:0xa8
    v_bitop3_b32 v6, v27, s34, v6 bitop3:0xbe
    v_bitop3_b32 v6, v31, s34, v6 bitop3:0xbe
    v_cmp_ne_u32 vcc, 0, v6
    s_cbranch_vccz L_ypoll_ok
    s_mov_b64 exec, vcc
    s_sub_u32 s40, s40, 1
    s_cbranch_scc0 L_ypoll
L_ypoll_ok:
    s_mov_b64 exec, -1
    v_perm_b32 v27, v25, v24, s53
    v_perm_b32 v31, v29, v28, s53
    v_pk_add_f32 v[26:27], v[26:27], v[30:31]
    v_pk_add_f32 v[24:25], v[24:25], v[28:29]
    s_nop 1
    v_permlane32_swap_b32 v24, v26
    v_permlane32_swap_b32 v25, v27
    v_add_f32 v24, v24, v26
    v_add_f32 v25, v25, v27
    s_nop 1
    v_permlane16_swap_b32 v24, v25
    v_add_f32 v24, v24, v25
    s_nop 1
    v_add_f32_dpp v24, v24, v24 row_ror:8 row_mask:0xf bank_mask:0xf
    s_nop 1
    v_add_f32_dpp v24, v24, v24 row_ror:4 row_mask:0xf bank_mask:0xf
    ds_write_b32 v155, v24 offset:1536
    s_cmp_lg_u32 s6, 7
    s_waitcnt lgkmcnt(0)
    s_barrier
    s_cbranch_scc1 L_epoch
    ds_read_b128 v[24:27], v7 offset:1536
    ds_read_b128 v[28:31], v7 offset:1552
    s_mov_b32 exec_lo, 0x000f000f
    s_mov_b32 exec_hi, 0x000f000f
    s_waitcnt lgkmcnt(1)
    v_pk_add_f32 v[24:25], v[24:25], v[26:27]
    s_waitcnt lgkmcnt(0)
    v_pk_add_f32 v[28:29], v[28:29], v[30:31]
    v_pk_add_f32 v[24:25], v[24:25], v[28:29]
    v_add_f32 v24, v24, v25
    v_cvt_pk_bf16_f32 v24, v24, v24
    global_store_short v4, v24, s[28:29] nt
L_s_exit:
L_end:
    s_endpgm
L_epoch:
    s_or_b32 s41, s61, s6
    s_cbranch_scc1 L_s_exit
    v_mov_b32 v5, 12
    v_mov_b32 v6, s34
    s_mov_b64 exec, 1
    global_store_dword v5, v6, s[32:33] nt
    s_branch L_s_exit
L_s_exit2:
    s_endpgm
.section .rodata,"a"
.p2align 6
.amdhsa_kernel gated_mix__sliding_block_cached__swiglu_ffn__decode_kernel
  .amdhsa_next_free_vgpr 168
  .amdhsa_next_free_sgpr 64
  .amdhsa_accum_offset 168
  .amdhsa_group_segment_fixed_size 0
  .amdhsa_kernarg_size 104
  .amdhsa_user_sgpr_count 2
  .amdhsa_user_sgpr_kernarg_segment_ptr 1
  .amdhsa_system_sgpr_workgroup_id_x 1
.end_amdhsa_kernel
```
